```python
import torch

def _softmax(x, axis=-1):
    return torch.softmax(x, dim=axis)
def _gelu(x):
    return torch.nn.functional.gelu(x, approximate="tanh")
def _silu(x):
    return torch.nn.functional.silu(x)
def _sigmoid(x):
    return torch.sigmoid(x)
def _layernorm(x, axis=-1, eps=1e-5):
    m = x.mean(dim=axis, keepdim=True)
    v = x.var(dim=axis, keepdim=True, unbiased=False)
    return (x - m) / torch.sqrt(v + eps)
def _scatter_add(tgt, idx, src, axis=0):
    return tgt.clone().index_add_(axis, idx, src)
def _segment_sum(src, seg, n):
    out = torch.zeros((n,) + src.shape[1:], dtype=src.dtype)
    return out.index_add_(0, seg, src)
def _pad(x, pw):
    flat = tuple(v for pair in reversed(pw) for v in pair)
    return torch.nn.functional.pad(x, flat)

kernel_name = 'interleave_layers__sliding_block_cached__dense_activation_silu__decode'

def setup_inputs():

    _w = (lambda a: (lambda t: t.to(torch.bfloat16) if t.is_floating_point() else t)(torch.as_tensor(a)))
    def _A_setup():
        B, Sq, D = 1, 1, 512
        Hq, Hkv, Sk, Dh = 32, 8, 16384, 128
        assert Hq % Hkv == 0, (Hq, Hkv)
        return {
            "x": _w((lambda *s: torch.randn(*s, dtype=torch.bfloat16) * 0.05)(B, Sq, D)),
            "k_cache": _w((lambda *s: torch.randn(*s, dtype=torch.bfloat16) * 0.8)(B, Hkv, Sk, Dh)),
            "v_cache": _w((lambda *s: torch.randn(*s, dtype=torch.bfloat16) * 1.6)(B, Hkv, Sk, Dh)),
            "wq": _w((lambda *s: torch.randn(*s, dtype=torch.bfloat16) * 0.8)(D, Hq * Dh) * (D ** -0.5)),
            "wo": _w((lambda *s: torch.randn(*s, dtype=torch.bfloat16) * 1.6)(Hq * Dh, D) * ((Hq * Dh) ** -0.5)),
        }
    _A_in = _A_setup()

    def _B_setup():
        B, S, D, F = 1, 1, 512, 1792
        return {
            "x": _w((lambda *s: torch.randn(*s, dtype=torch.bfloat16) * 0.05)(B, S, D)),
            "w1": _w((lambda *s: torch.randn(*s, dtype=torch.bfloat16) * 0.4)(D, F) * (D ** -0.5)),
            "w2": _w((lambda *s: torch.randn(*s, dtype=torch.bfloat16) * 0.4)(F, D) * (F ** -0.5)),
        }
    _B_in = _B_setup()

    return {
        "A_x": _A_in["x"],
        "A_k_cache": _A_in["k_cache"],
        "A_v_cache": _A_in["v_cache"],
        "A_wq": _A_in["wq"],
        "A_wo": _A_in["wo"],
        "B_x": _B_in["x"],
        "B_w1": _B_in["w1"],
        "B_w2": _B_in["w2"],
    }

def reference(A_x, A_k_cache, A_v_cache, A_wq, A_wo, B_x, B_w1, B_w2):
    def _A_ref(x, k_cache, v_cache, wq, wo):
        B, Sq, D = x.shape
        Hq, Dh = 32, 128
        Hkv, Sk = k_cache.shape[1], k_cache.shape[2]
        W = min(4096, max(256, Sk // 4))
        rep = Hq // Hkv
        q = (lambda x, *d: x.permute(*d))((x @ wq).reshape(B, Sq, Hq, Dh), 0, 2, 1, 3)
        k = (lambda x, n, axis: torch.repeat_interleave(x, n, dim=axis))(k_cache[:, :, Sk - W:, :], rep, axis=1)
        v = (lambda x, n, axis: torch.repeat_interleave(x, n, dim=axis))(v_cache[:, :, Sk - W:, :], rep, axis=1)
        scores = torch.einsum("bhqd,bhkd->bhqk", q, k) * (Dh ** -0.5)
        p = _softmax(scores, axis=-1)
        o = torch.einsum("bhqk,bhkd->bhqd", p, v)
        return (lambda x, *d: x.permute(*d))(o, 0, 2, 1, 3).reshape(B, Sq, Hq * Dh) @ wo

    def _B_ref(x, w1, w2):
        h = torch.einsum("bsd,df->bsf", x, w1)
        h = _silu(h)
        out = torch.einsum("bsf,fd->bsd", h, w2)
        return out

    x = A_x
    x = x + _A_ref(_layernorm(x, axis=-1), A_k_cache, A_v_cache, A_wq, A_wo)
    x = x + _B_ref(_layernorm(x, axis=-1), B_w1, B_w2)
    x = x + _A_ref(_layernorm(x, axis=-1), A_k_cache, A_v_cache, A_wq, A_wo)
    x = x + _B_ref(_layernorm(x, axis=-1), B_w1, B_w2)
    return x
```

```asm
; @launch grid=(256,1,1) block=(256,1,1) lds=143616
.amdgcn_target "amdgcn-amd-amdhsa--gfx950"
.text
.globl interleave_layers__sliding_block_cached__dense_activation_silu__decode_kernel
.p2align 8
.type interleave_layers__sliding_block_cached__dense_activation_silu__decode_kernel,@function
interleave_layers__sliding_block_cached__dense_activation_silu__decode_kernel:
    s_cmp_ge_u32 s2, 256
    s_cbranch_scc1 END
    s_load_dwordx16 s[4:19], s[0:1], 0
    s_load_dwordx4 s[20:23], s[0:1], 64
    s_load_dwordx2 s[24:25], s[0:1], 80
    s_getpc_b64 s[28:29]
CODE_REF:
    v_lshlrev_b32 v236, 6, v0
    v_min_u32 v236, CODE_END-CODE_REF-4, v236
    v_mov_b32 v237, s29
    v_add_co_u32 v236, vcc, s28, v236
    v_addc_co_u32 v237, vcc, 0, v237, vcc
    global_load_dword v236, v[236:237], off
    v_lshrrev_b32 v4, 6, v0
    v_and_b32 v1, 63, v0
    s_and_b32 s69, s2, 7
    v_readfirstlane_b32 s68, v4
    s_lshr_b32 s70, s2, 3
    s_lshr_b32 s71, s2, 6
    s_and_b32 s72, s70, 7
    v_and_b32 v2, 15, v0
    v_bfe_u32 v3, v0, 4, 2
    v_lshrrev_b32 v4, 3, v1
    v_and_b32 v5, 2, v4
    v_and_b32 v6, 7, v1
    v_xor_b32 v5, v5, v6
    v_lshlrev_b32 v5, 4, v5
    v_lshl_or_b32 v41, v4, 13, v5
    v_lshl_or_b32 v42, v4, 10, v5
    v_xor_b32 v5, v2, v3
    v_lshlrev_b32 v5, 4, v5
    v_lshl_or_b32 v43, v3, 8, v5
    v_lshlrev_b32 v4, 4, v1
    s_lshl_b32 s26, s71, 6
    s_lshl_b32 s27, s68, 4
    s_add_u32 s26, s26, s27
    v_add_lshl_u32 v5, v2, s26, 2
    s_lshl_b32 s26, s71, 2
    s_add_u32 s26, s26, s68
    s_lshl_b32 s26, s26, 18
    s_lshl_b32 s27, s69, 10
    s_add_u32 s26, s26, s27
    s_lshl_b32 s27, s72, 7
    s_add_u32 s26, s26, s27
    s_waitcnt lgkmcnt(0)
    s_mov_b32 s64, s4
    s_mov_b32 s65, s5
    s_mov_b32 s66, 1024
    s_mov_b32 s67, 0x00020000
    buffer_load_dword v49, v5, s[64:67], 0 offen
    buffer_load_dwordx4 v[168:171], v4, s[64:67], 0 offen
    s_add_u32 s36, s10, s26
    s_addc_u32 s37, s11, 0
    s_mov_b32 s38, 254080
    s_mov_b32 s39, 0x00020000
    s_mul_i32 s84, s68, 4352
    s_add_u32 m0, s84, 0
    s_mov_b32 s83, 0
    buffer_load_dwordx4 v41, s[36:39], s83 offen nt lds
    s_add_u32 m0, s84, 1088
    s_mov_b32 s83, 65536
    buffer_load_dwordx4 v41, s[36:39], s83 offen nt lds
    s_add_u32 m0, s84, 2176
    s_mov_b32 s83, 131072
    buffer_load_dwordx4 v41, s[36:39], s83 offen nt lds
    s_add_u32 m0, s84, 3264
    s_mov_b32 s83, 196608
    buffer_load_dwordx4 v41, s[36:39], s83 offen nt lds
    s_add_u32 s32, s24, 0x100000
    s_addc_u32 s33, s25, 0
    s_mov_b32 s34, 237568
    s_mov_b32 s35, 0x00020000
    v_mov_b32 v6, 135168
    buffer_load_dword v48, v6, s[32:35], 0 offen sc1
    s_lshl_b32 s26, s70, 2
    s_add_u32 s26, s26, s68
    s_lshl_b32 s26, s26, 13
    s_lshl_b32 s27, s69, 22
    s_add_u32 s26, s26, s27
    s_add_u32 s26, s26, 3145728
    s_add_u32 s40, s6, s26
    s_addc_u32 s41, s7, 0
    s_mov_b32 s42, 8192
    s_mov_b32 s43, 0x00020000
    s_add_u32 s44, s8, s26
    s_addc_u32 s45, s9, 0
    s_mov_b32 s46, 8192
    s_mov_b32 s47, 0x00020000
    s_lshl_b32 s27, s69, 17
    s_add_u32 s28, s24, s27
    s_addc_u32 s29, s25, 0
    s_mov_b32 s30, 131072
    s_mov_b32 s31, 0x00020000
    s_mov_b32 s79, 0xff81ff81
    s_mul_i32 s26, s70, 3712
    s_add_u32 s26, s26, 0
    v_mov_b32 v140, s79
    v_mov_b32 v141, s79
    v_mov_b32 v142, s79
    v_mov_b32 v143, s79
    v_lshlrev_b32 v6, 4, v0
    v_cmp_gt_u32 vcc, 232, v0
    v_mov_b32 v8, 0x7ff00000
    v_and_b32 v7, 127, v0
    v_cndmask_b32 v6, v8, v6, vcc
    v_lshlrev_b32 v7, 2, v7
    s_lshl_b32 s27, s2, 9
    buffer_store_dwordx4 v[140:143], v6, s[28:31], s26 offen sc1
    buffer_store_dword v140, v7, s[32:35], s27 offen sc1
    s_cmp_lt_u32 s70, 16
    s_cbranch_scc1 kl_a
    s_mul_i32 s84, s68, 8704
    s_add_u32 m0, s84, 34816
    s_mov_b32 s83, 0
    buffer_load_dwordx4 v43, s[40:43], s83 offen nt lds
    s_add_u32 m0, s84, 35904
    s_mov_b32 s83, 1024
    buffer_load_dwordx4 v43, s[40:43], s83 offen nt lds
    s_add_u32 m0, s84, 36992
    s_mov_b32 s83, 2048
    buffer_load_dwordx4 v43, s[40:43], s83 offen nt lds
    s_add_u32 m0, s84, 38080
    s_mov_b32 s83, 3072
    buffer_load_dwordx4 v43, s[40:43], s83 offen nt lds
    s_add_u32 m0, s84, 39168
    s_mov_b32 s83, 4096
    buffer_load_dwordx4 v43, s[40:43], s83 offen nt lds
    s_add_u32 m0, s84, 40256
    s_mov_b32 s83, 5120
    buffer_load_dwordx4 v43, s[40:43], s83 offen nt lds
kl_a:
    v_and_b32 v224, 3, v2
    v_lshrrev_b32 v225, 2, v2
    v_mov_b32 v226, 0x7ff00000
    v_mov_b32 v47, 0x3727c5ac
    s_mov_b32 s80, 0x3e0293ee
    s_mov_b32 s78, 400000
    s_mov_b32 s73, 59392
    s_mov_b32 s74, 63488
    s_mov_b32 s75, 0
    s_mov_b32 s76, 2
    s_mov_b32 s77, 0
    s_getreg_b32 s82, hwreg(HW_REG_XCC_ID, 0, 4)
    s_lshl_b32 s26, s68, 6
    s_add_u32 s26, s26, 143104
    v_lshl_add_u32 v10, v2, 2, s26
    v_lshlrev_b32 v9, 4, v3
    v_add_u32 v4, 143104, v9
    v_mov_b32 v5, 143360
    v_cmp_eq_u32 vcc, 4, v2
    s_nop 1
    v_cndmask_b32 v11, v4, v5, vcc
    s_lshl_b32 s3, s72, 2
    s_add_u32 s3, s3, s68
    s_mul_i32 s26, s3, 96
    s_mul_i32 s27, s71, 3072
    s_add_u32 s26, s26, s27
    s_add_u32 s26, s26, 118784
    v_mad_u32_u24 v4, v3, 24, s26
    v_cmp_eq_u32 vcc, 0, v2
    s_nop 1
    v_cndmask_b32 v12, v226, v4, vcc
    v_mul_u32_u24 v4, 1088, v3
    v_lshl_add_u32 v4, v225, 7, v4
    v_lshl_add_u32 v4, v224, 3, v4
    v_lshrrev_b32 v5, 1, v225
    v_xor_b32 v5, s68, v5
    v_lshl_add_u32 v34, v5, 5, v4
    v_lshlrev_b32 v4, 1, v3
    v_xor_b32 v4, v2, v4
    v_lshlrev_b32 v4, 4, v4
    v_lshl_or_b32 v44, v3, 8, v4
    v_mul_u32_u24 v4, 12, v0
    v_add_u32 v13, 118784, v4
    s_mul_i32 s4, s69, 12288
    s_add_u32 s4, s4, 139264
    s_add_u32 s5, s4, 6144
    v_subrev_u32 v92, 118784, v12
    s_lshl_b32 s26, s69, 5
    s_add_u32 s26, s26, s70
    s_lshl_b32 s26, s26, 2
    s_add_u32 s26, s26, 131072
    v_mov_b32 v4, s26
    v_cmp_eq_u32 vcc, 0, v0
    s_nop 1
    v_cndmask_b32 v93, v226, v4, vcc
    v_mov_b32 v72, 0x3f803f80
    v_mov_b32 v73, 0x3f803f80
    v_mov_b32 v74, 0x3f803f80
    v_mov_b32 v75, 0x3f803f80
    v_lshlrev_b32 v4, 2, v1
    v_add_u32 v4, 143360, v4
    ds_write_b32 v4, v72
    s_mov_b64 exec, 0
    s_mov_b32 s77, 1
    s_cmp_eq_u32 s68, 0
    s_cbranch_scc1 entry_5
    s_cmp_eq_u32 s68, 1
    s_cbranch_scc1 entry_2
    s_cmp_eq_u32 s68, 2
    s_cbranch_scc1 entry_3
    s_branch entry_1
dry_done:
    s_barrier
dry_done2:
    s_mov_b64 exec, -1
    s_mov_b32 s77, 0
    s_cmp_lt_u32 s70, 16
    s_cbranch_scc1 kl_b
    s_waitcnt vmcnt(13)
    s_branch kl_c
kl_b:
    s_waitcnt vmcnt(7)
kl_c:
    ds_write_b32 v10, v49
    v_lshlrev_b32 v58, 16, v49
    v_and_b32 v59, 0xffff0000, v49
    v_mov_b32 v62, 0
    v_mov_b32 v63, 0
    v_lshlrev_b32 v4, 16, v168
    v_and_b32 v5, 0xffff0000, v168
    v_add_f32 v62, v62, v4
    v_fma_f32 v63, v4, v4, v63
    v_add_f32 v62, v62, v5
    v_fma_f32 v63, v5, v5, v63
    v_lshlrev_b32 v4, 16, v169
    v_and_b32 v5, 0xffff0000, v169
    v_add_f32 v62, v62, v4
    v_fma_f32 v63, v4, v4, v63
    v_add_f32 v62, v62, v5
    v_fma_f32 v63, v5, v5, v63
    v_lshlrev_b32 v4, 16, v170
    v_and_b32 v5, 0xffff0000, v170
    v_add_f32 v62, v62, v4
    v_fma_f32 v63, v4, v4, v63
    v_add_f32 v62, v62, v5
    v_fma_f32 v63, v5, v5, v63
    v_lshlrev_b32 v4, 16, v171
    v_and_b32 v5, 0xffff0000, v171
    v_add_f32 v62, v62, v4
    v_fma_f32 v63, v4, v4, v63
    v_add_f32 v62, v62, v5
    v_fma_f32 v63, v5, v5, v63
    s_nop 0
    v_add_f32_dpp v62, v62, v62 row_ror:8 row_mask:0xf bank_mask:0xf
    v_add_f32_dpp v63, v63, v63 row_ror:8 row_mask:0xf bank_mask:0xf
    s_nop 0
    v_add_f32_dpp v62, v62, v62 row_ror:4 row_mask:0xf bank_mask:0xf
    v_add_f32_dpp v63, v63, v63 row_ror:4 row_mask:0xf bank_mask:0xf
    s_nop 0
    v_add_f32_dpp v62, v62, v62 row_ror:2 row_mask:0xf bank_mask:0xf
    v_add_f32_dpp v63, v63, v63 row_ror:2 row_mask:0xf bank_mask:0xf
    s_nop 0
    v_add_f32_dpp v62, v62, v62 row_ror:1 row_mask:0xf bank_mask:0xf
    v_add_f32_dpp v63, v63, v63 row_ror:1 row_mask:0xf bank_mask:0xf
    v_mov_b32 v4, v62
    v_mov_b32 v5, v63
    s_nop 0
    v_permlane16_swap_b32 v62, v4
    v_permlane16_swap_b32 v63, v5
    v_add_f32 v62, v62, v4
    v_add_f32 v63, v63, v5
    v_mov_b32 v4, v62
    v_mov_b32 v5, v63
    s_nop 0
    v_permlane32_swap_b32 v62, v4
    v_permlane32_swap_b32 v63, v5
    v_add_f32 v62, v62, v4
    v_add_f32 v63, v63, v5
    v_mul_f32 v50, 0x3b000000, v62
    v_fmamk_f32 v51, v63, 0x3b000000, v47
    v_fma_f32 v51, -v50, v50, v51
    v_max_f32 v51, v51, v47
    v_rsq_f32 v51, v51
    s_cmp_ge_u32 s70, 16
    s_cbranch_scc1 kl_d
    s_mul_i32 s84, s68, 8704
    s_add_u32 m0, s84, 34816
    s_mov_b32 s83, 0
    buffer_load_dwordx4 v43, s[40:43], s83 offen nt lds
    s_add_u32 m0, s84, 35904
    s_mov_b32 s83, 1024
    buffer_load_dwordx4 v43, s[40:43], s83 offen nt lds
    s_add_u32 m0, s84, 36992
    s_mov_b32 s83, 2048
    buffer_load_dwordx4 v43, s[40:43], s83 offen nt lds
    s_add_u32 m0, s84, 38080
    s_mov_b32 s83, 3072
    buffer_load_dwordx4 v43, s[40:43], s83 offen nt lds
    s_add_u32 m0, s84, 39168
    s_mov_b32 s83, 4096
    buffer_load_dwordx4 v43, s[40:43], s83 offen nt lds
    s_add_u32 m0, s84, 40256
    s_mov_b32 s83, 5120
    buffer_load_dwordx4 v43, s[40:43], s83 offen nt lds
kl_d:
    s_mul_i32 s84, s68, 8704
    s_add_u32 m0, s84, 41344
    s_mov_b32 s83, 6144
    buffer_load_dwordx4 v43, s[40:43], s83 offen nt lds
    s_waitcnt vmcnt(7) lgkmcnt(0)
    s_barrier
    ds_read_b64_tr_b16 v[176:177], v34 offset:0
    ds_read_b64_tr_b16 v[178:179], v34 offset:512
    ds_read_b128 v[96:99], v11 offset:0
    ds_read_b64_tr_b16 v[180:181], v34 offset:4352
    ds_read_b64_tr_b16 v[182:183], v34 offset:4864
    ds_read_b128 v[100:103], v11 offset:64
    ds_read_b64_tr_b16 v[184:185], v34 offset:8704
    ds_read_b64_tr_b16 v[186:187], v34 offset:9216
    ds_read_b128 v[104:107], v11 offset:128
    ds_read_b64_tr_b16 v[188:189], v34 offset:13056
    ds_read_b64_tr_b16 v[190:191], v34 offset:13568
    ds_read_b128 v[108:111], v11 offset:192
    v_readfirstlane_b32 s26, v48
    s_mul_i32 s81, s26, 0x9E3779B1
    s_add_u32 s81, s81, 0x7F4A7C15
    s_and_b32 s81, s81, 0xFFFFFFF0
    s_xor_b32 s27, s81, s82
    v_mov_b32 v94, s27
    s_waitcnt lgkmcnt(9)
    v_mfma_f32_16x16x32_bf16 v[128:131], v[176:179], v[96:99], 0
    s_waitcnt lgkmcnt(6)
    v_mfma_f32_16x16x32_bf16 v[128:131], v[180:183], v[100:103], v[128:131]
    s_waitcnt lgkmcnt(3)
    v_mfma_f32_16x16x32_bf16 v[128:131], v[184:187], v[104:107], v[128:131]
    s_waitcnt lgkmcnt(0)
    v_mfma_f32_16x16x32_bf16 v[128:131], v[188:191], v[108:111], v[128:131]
    s_nop 7
    v_mov_b32 v164, v128
    v_mov_b32 v165, v129
    v_mov_b32 v166, v130
    v_mov_b32 v167, v131
    v_mov_b32_dpp v132, v128 row_shl:4 row_mask:0xf bank_mask:0xf
    v_mov_b32_dpp v133, v129 row_shl:4 row_mask:0xf bank_mask:0xf
    v_mov_b32_dpp v134, v130 row_shl:4 row_mask:0xf bank_mask:0xf
    v_mov_b32_dpp v135, v131 row_shl:4 row_mask:0xf bank_mask:0xf
    v_fma_f32 v128, -v50, v132, v128
    v_fma_f32 v129, -v50, v133, v129
    v_fma_f32 v130, -v50, v134, v130
    v_fma_f32 v131, -v50, v135, v131
    v_mul_f32 v140, v128, v51
    v_mul_f32 v141, v129, v51
    v_mul_f32 v144, v130, v51
    v_mul_f32 v145, v131, v51
    v_bitop3_b32 v142, v140, v141, s81 bitop3:0x96
    v_bitop3_b32 v146, v144, v145, s81 bitop3:0x96
    buffer_store_dwordx3 v[140:142], v12, s[28:31], 0 offen
    buffer_store_dwordx3 v[144:146], v12, s[28:31], 0 offen offset:12
    buffer_store_dwordx3 v[140:142], v92, s[32:35], s4 offen sc1
    buffer_store_dwordx3 v[144:146], v92, s[32:35], s4 offen offset:12 sc1
    buffer_store_dword v94, v93, s[32:35], 0 offen sc1
    s_mul_i32 s84, s68, 8704
    s_add_u32 m0, s84, 42432
    s_mov_b32 s83, 7168
    buffer_load_dwordx4 v43, s[40:43], s83 offen nt lds
    s_lshl_b32 s26, s69, 4
    s_lshl_b32 s27, s71, 2
    s_add_u32 s26, s26, s27
    s_add_u32 s26, s26, s68
    s_lshl_b32 s26, s26, 15
    s_lshl_b32 s3, s72, 7
    s_add_u32 s26, s26, s3
    s_add_u32 s48, s12, s26
    s_addc_u32 s49, s13, 0
    s_mov_b32 s50, 31872
    s_mov_b32 s51, 0x00020000
    s_add_u32 s26, s27, s68
    s_mul_i32 s26, s26, 114688
    s_mul_i32 s27, s69, 448
    s_mul_i32 s84, s68, 9216
    s_add_u32 m0, s84, 69632
    s_mov_b32 s83, 0
    buffer_load_dwordx4 v44, s[44:47], s83 offen nt lds
    s_add_u32 s26, s26, s27
    s_lshl_b32 s27, s72, 6
    s_add_u32 s26, s26, s27
    s_add_u32 s52, s16, s26
    s_addc_u32 s53, s17, 0
    s_mov_b32 s54, 111168
    s_mov_b32 s55, 0x00020000
    s_cmp_eq_u32 s72, 7
    s_cselect_b32 s54, 0, s54
    s_mul_i32 s26, s69, 224
    s_mul_i32 s27, s71, 56
    s_add_u32 s26, s26, s27
    s_lshl_b32 s27, s68, 4
    s_add_u32 s26, s26, s27
    s_mov_b32 s83, 6144
    buffer_load_dwordx3 v[140:142], v13, s[28:31], 0 offen sc1
    buffer_load_dwordx3 v[144:146], v13, s[28:31], 0 offen offset:3072 sc1
    buffer_load_dwordx3 v[148:150], v13, s[28:31], s83 offen sc1
    buffer_load_dwordx3 v[152:154], v13, s[28:31], s83 offen offset:3072 sc1
    s_lshl_b32 s26, s26, 10
    s_add_u32 s26, s26, s3
    s_add_u32 s56, s18, s26
    s_addc_u32 s57, s19, 0
    s_mov_b32 s58, 15488
    s_mov_b32 s59, 0x00020000
    s_mov_b32 s60, s20
    s_mov_b32 s61, s21
    s_mov_b32 s62, 1024
    s_mov_b32 s63, 0x00020000
    s_lshl_b32 s3, s72, 2
    s_add_u32 s3, s3, s68
    v_lshlrev_b32 v9, 4, v3
    s_lshl_b32 s26, s3, 6
    s_mul_i32 s84, s68, 9216
    s_add_u32 m0, s84, 70784
    s_mov_b32 s83, 1024
    buffer_load_dwordx4 v44, s[44:47], s83 offen nt lds
    s_lshl_b32 s27, s71, 11
    s_add_u32 s26, s26, s27
    s_add_u32 s26, s26, 43008
    v_add_u32 v4, s26, v9
    v_add_u32 v5, 8192, v4
    v_cmp_eq_u32 vcc, 0, v2
    s_nop 1
    v_cndmask_b32 v4, v226, v4, vcc
    v_cmp_eq_u32 vcc, 4, v2
    s_nop 1
    v_cndmask_b32 v14, v4, v5, vcc
    s_lshl_b32 s26, s72, 1
    s_add_u32 s26, s26, s68
    s_lshl_b32 s26, s26, 6
    s_lshl_b32 s27, s71, 10
    s_add_u32 s26, s26, s27
    s_mul_i32 s84, s68, 9216
    s_add_u32 m0, s84, 71936
    s_mov_b32 s83, 2048
    buffer_load_dwordx4 v44, s[44:47], s83 offen nt lds
    s_add_u32 s26, s26, 32768
    s_cmp_ge_u32 s68, 2
    s_cselect_b32 s26, 0x7ff00000, s26
    s_cmp_eq_u32 s72, 7
    s_cselect_b32 s26, 0x7ff00000, s26
    v_add_u32 v4, s26, v9
    v_add_u32 v5, 4096, v4
    v_cmp_eq_u32 vcc, 0, v2
    s_nop 1
    v_cndmask_b32 v4, v226, v4, vcc
    v_cmp_eq_u32 vcc, 4, v2
    s_nop 1
    v_cndmask_b32 v32, v4, v5, vcc
    s_lshl_b32 s26, s71, 2
    s_add_u32 s26, s26, s68
    s_lshl_b32 s26, s26, 3
    s_mul_i32 s84, s68, 9216
    s_add_u32 m0, s84, 73088
    s_mov_b32 s83, 3072
    buffer_load_dwordx4 v44, s[44:47], s83 offen nt lds
    s_add_u32 s26, s26, 41984
    s_cmp_lg_u32 s72, 0
    s_cselect_b32 s26, 0x7ff00000, s26
    v_mov_b32 v4, s26
    v_cmp_eq_u32 vcc, 0, v1
    s_nop 1
    v_cndmask_b32 v15, v226, v4, vcc
    v_lshlrev_b32 v4, 3, v2
    v_add_u32 v17, 41984, v4
    v_lshlrev_b32 v5, 3, v0
    v_add_u32 v16, 43008, v5
    s_mul_i32 s26, s68, 288
    s_add_u32 s26, s26, 123392
    v_lshl_add_u32 v18, v1, 2, s26
    v_mul_u32_u24 v5, 288, v224
    s_mul_i32 s84, s68, 9216
    s_add_u32 m0, s84, 74240
    s_mov_b32 s83, 4096
    buffer_load_dwordx4 v44, s[44:47], s83 offen nt lds
    v_add3_u32 v19, v5, v9, 0
    v_add_u32 v19, 123392, v19
    s_mul_i32 s26, s68, 2432
    s_add_u32 s26, s26, 124544
    v_mul_u32_u24 v5, 608, v224
    v_mul_u32_u24 v6, 144, v225
    v_add3_u32 v5, v5, v6, v9
    v_add_u32 v20, s26, v5
    s_lshl_b32 s26, s68, 3
    s_add_u32 s26, s26, 134272
    v_lshl_add_u32 v21, v224, 5, s26
    s_mul_i32 s26, s68, 608
    s_add_u32 s26, s26, 124544
    v_mul_u32_u24 v5, 144, v3
    s_mov_b32 s83, 6144
    buffer_load_dwordx3 v[232:234], v13, s[28:31], 0 offen sc1
    buffer_load_dwordx3 v[236:238], v13, s[28:31], 0 offen offset:3072 sc1
    buffer_load_dwordx3 v[240:242], v13, s[28:31], s83 offen sc1
    buffer_load_dwordx3 v[244:246], v13, s[28:31], s83 offen offset:3072 sc1
    v_add3_u32 v22, v5, v4, s26
    s_lshl_b32 s26, s68, 5
    s_add_u32 s27, s26, 134272
    v_mov_b32 v23, s27
    s_add_u32 s26, s26, s70
    s_lshl_b32 s26, s26, 8
    v_lshl_add_u32 v24, v1, 2, s26
    s_and_b32 s26, s70, 15
    s_lshl_b32 s26, s26, 4
    s_lshr_b32 s27, s70, 4
    s_lshl_b32 s27, s27, 3
    s_add_u32 s26, s26, s27
    s_lshl_b32 s27, s68, 8
    s_add_u32 s26, s26, s27
    s_mul_i32 s84, s68, 9216
    s_add_u32 m0, s84, 75392
    s_mov_b32 s83, 5120
    buffer_load_dwordx4 v44, s[44:47], s83 offen nt lds
    s_add_u32 s26, s26, 40960
    v_mov_b32 v4, s26
    v_cmp_eq_u32 vcc, 0, v1
    s_nop 1
    v_cndmask_b32 v25, v226, v4, vcc
    s_lshl_b32 s26, s71, 2
    s_add_u32 s26, s26, s68
    s_lshl_b32 s26, s26, 11
    v_lshl_add_u32 v26, v1, 4, s26
    v_lshlrev_b32 v4, 6, v3
    v_lshl_add_u32 v4, v2, 2, v4
    v_add_u32 v31, s26, v4
    s_lshl_b32 s26, s71, 8
    s_add_u32 s26, s26, 40960
    v_lshl_add_u32 v27, v2, 4, s26
    s_mul_i32 s84, s68, 9216
    s_add_u32 m0, s84, 76544
    s_mov_b32 s83, 6144
    buffer_load_dwordx4 v44, s[44:47], s83 offen nt lds
    s_mul_i32 s26, s68, 2176
    s_add_u32 s26, s26, 134400
    v_add_u32 v28, s26, v43
    v_mul_u32_u24 v4, 1088, v225
    v_lshl_add_u32 v4, v224, 8, v4
    v_xor_b32 v5, v3, v224
    v_lshl_add_u32 v4, v5, 4, v4
    v_add_u32 v29, 134400, v4
    s_mul_i32 s26, s68, 8704
    s_add_u32 s26, s26, 34816
    v_add_u32 v36, s26, v4
    s_mul_i32 s26, s68, 9216
    s_add_u32 s26, s26, 69632
    v_mul_u32_u24 v4, 1152, v3
    s_mul_i32 s84, s68, 9216
    s_add_u32 m0, s84, 77696
    s_mov_b32 s83, 7168
    buffer_load_dwordx4 v44, s[44:47], s83 offen nt lds
    v_lshl_add_u32 v4, v225, 8, v4
    v_lshl_add_u32 v4, v224, 3, v4
    v_add_u32 v4, s26, v4
    v_xor_b32 v5, 0, v225
    v_lshl_add_u32 v37, v5, 5, v4
    v_xor_b32 v5, 1, v225
    v_lshl_add_u32 v38, v5, 5, v4
    v_xor_b32 v5, 2, v225
    v_lshl_add_u32 v39, v5, 5, v4
    v_xor_b32 v5, 3, v225
    v_lshl_add_u32 v40, v5, 5, v4
    v_lshl_add_u32 v4, v3, 3, v225
    v_lshlrev_b32 v4, 6, v4
    v_lshl_add_u32 v4, v224, 3, v4
    s_and_b32 s26, s68, 1
    s_lshl_b32 s26, s26, 5
    s_add_u32 s27, s26, 106496
    v_add_u32 v35, s27, v4
    s_lshl_b32 s27, s72, 1
    s_lshr_b32 s3, s68, 1
    s_add_u32 s27, s27, s3
    s_lshl_b32 s27, s27, 11
    s_add_u32 s26, s26, s27
    s_lshl_b32 s27, s69, 2
    s_add_u32 s27, s27, s71
    s_lshl_b32 s27, s27, 6
    s_add_u32 s26, s26, s27
    v_lshl_add_u32 v4, v3, 3, s26
    v_cmp_eq_u32 vcc, 0, v2
    s_nop 1
    v_cndmask_b32 v30, v226, v4, vcc
    v_lshrrev_b32 v4, 3, v2
    v_lshlrev_b32 v4, 5, v4
    v_lshl_add_u32 v4, v3, 3, v4
    v_and_or_b32 v4, v2, 7, v4
    s_mul_i32 s26, s71, 224
    s_add_u32 s26, s26, 32768
    v_lshl_add_u32 v5, v4, 2, s26
    v_cmp_gt_u32 vcc, 56, v4
    s_nop 1
    v_cndmask_b32 v33, v226, v5, vcc
    v_lshrrev_b32 v4, 2, v1
    v_mul_u32_u24 v4, 3584, v4
    v_and_b32 v5, 3, v1
    v_lshl_add_u32 v45, v5, 4, v4
    v_mov_b32 v4, 0x3f80
    v_mov_b32 v5, 0x3f800000
    v_mov_b32 v6, 0
    v_cmp_eq_u32 vcc, 0, v224
    s_nop 1
    v_cndmask_b32 v6, v6, v4, vcc
    v_cmp_eq_u32 vcc, 1, v224
    s_nop 1
    v_cndmask_b32 v68, v6, v5, vcc
    v_mov_b32 v69, v68
    v_mov_b32 v70, v68
    v_mov_b32 v71, v68
    v_mov_b32 v76, 0
    v_mov_b32 v77, 0
    v_mov_b32 v78, 0
    v_mov_b32 v79, 0
    v_mov_b32 v80, 0
    v_mov_b32 v81, 0
    v_mov_b32 v82, 0
    v_mov_b32 v83, 0
    v_mov_b32 v84, 0
    v_mov_b32 v85, 0
    v_mov_b32 v86, 0
    v_mov_b32 v87, 0
    v_mov_b32 v88, 0
    v_mov_b32 v89, 0
    v_mov_b32 v90, 0
    v_mov_b32 v91, 0
    s_waitcnt vmcnt(16)
    ds_read_b128 a[0:3], v36 offset:0
    ds_read_b128 a[4:7], v36 offset:64
    ds_read_b128 a[8:11], v36 offset:128
    ds_read_b128 a[12:15], v36 offset:192
    ds_read_b128 a[16:19], v36 offset:4352
    ds_read_b128 a[20:23], v36 offset:4416
    ds_read_b128 a[24:27], v36 offset:4480
    ds_read_b128 a[28:31], v36 offset:4544
    s_waitcnt vmcnt(11)
    v_bitop3_b32 v142, v140, v141, v142 bitop3:0x96
    v_bitop3_b32 v146, v144, v145, v146 bitop3:0x96
    v_bitop3_b32 v150, v148, v149, v150 bitop3:0x96
    v_bitop3_b32 v154, v152, v153, v154 bitop3:0x96
    v_xor_b32 v142, s81, v142
    v_xor_b32 v146, s81, v146
    v_xor_b32 v150, s81, v150
    v_xor_b32 v154, s81, v154
    v_or3_b32 v142, v142, v146, v150
    v_or_b32 v142, v142, v154
    v_cmp_ne_u32 vcc, 0, v142
    v_pk_add_f32 v[140:141], v[140:141], v[144:145]
    v_pk_add_f32 v[148:149], v[148:149], v[152:153]
    v_pk_add_f32 v[64:65], v[140:141], v[148:149]
    s_cbranch_vccz hookA_ok
    s_waitcnt vmcnt(3)
    v_bitop3_b32 v234, v232, v233, v234 bitop3:0x96
    v_bitop3_b32 v238, v236, v237, v238 bitop3:0x96
    v_bitop3_b32 v242, v240, v241, v242 bitop3:0x96
    v_bitop3_b32 v246, v244, v245, v246 bitop3:0x96
    v_xor_b32 v234, s81, v234
    v_xor_b32 v238, s81, v238
    v_xor_b32 v242, s81, v242
    v_xor_b32 v246, s81, v246
    v_or3_b32 v234, v234, v238, v242
    v_or_b32 v234, v234, v246
    v_cmp_ne_u32 vcc, 0, v234
    v_pk_add_f32 v[232:233], v[232:233], v[236:237]
    v_pk_add_f32 v[240:241], v[240:241], v[244:245]
    v_pk_add_f32 v[64:65], v[232:233], v[240:241]
    s_cbranch_vccz hookA_ok
    s_branch hookA_f
hookA_chk:
    v_bitop3_b32 v142, v140, v141, v142 bitop3:0x96
    v_bitop3_b32 v146, v144, v145, v146 bitop3:0x96
    v_bitop3_b32 v150, v148, v149, v150 bitop3:0x96
    v_bitop3_b32 v154, v152, v153, v154 bitop3:0x96
    v_xor_b32 v142, s81, v142
    v_xor_b32 v146, s81, v146
    v_xor_b32 v150, s81, v150
    v_xor_b32 v154, s81, v154
    v_or3_b32 v142, v142, v146, v150
    v_or_b32 v142, v142, v154
    v_cmp_ne_u32 vcc, 0, v142
    v_pk_add_f32 v[140:141], v[140:141], v[144:145]
    v_pk_add_f32 v[148:149], v[148:149], v[152:153]
    v_pk_add_f32 v[64:65], v[140:141], v[148:149]
    s_cbranch_vccnz hookA_f
hookA_ok:
    v_lshlrev_b32 v53, 4, v1
    v_add_u32 v53, 131072, v53
    buffer_load_dwordx4 v[160:163], v53, s[32:35], 0 offen sc1
    v_lshlrev_b32 v54, 4, v0
    v_min_u32 v54, 3696, v54
    s_mul_i32 s83, s70, 3712
    buffer_load_dwordx4 v[232:235], v54, s[28:31], s83 offen sc1
    buffer_load_dword v236, off, s[52:55], 0
    buffer_load_dword v236, off, s[56:59], 0
    s_branch q_ready
hookA_f:
    s_sub_u32 s78, s78, 1
    s_cbranch_scc0 hookA_re
    s_mov_b32 s78, 0
    s_branch hookA_ok
hookA_re:
    s_and_b32 s83, s78, 7
    s_cbranch_scc1 hookA_r1
    v_subrev_u32 v4, 118784, v13
    buffer_load_dwordx3 v[140:142], v4, s[32:35], s4 offen sc1
    buffer_load_dwordx3 v[144:146], v4, s[32:35], s4 offen offset:3072 sc1
    buffer_load_dwordx3 v[148:150], v4, s[32:35], s5 offen sc1
    buffer_load_dwordx3 v[152:154], v4, s[32:35], s5 offen offset:3072 sc1
    s_waitcnt vmcnt(0)
    s_branch hookA_chk
hookA_r1:
    s_mov_b32 s83, 6144
    buffer_load_dwordx3 v[140:142], v13, s[28:31], 0 offen sc1
    buffer_load_dwordx3 v[144:146], v13, s[28:31], 0 offen offset:3072 sc1
    buffer_load_dwordx3 v[148:150], v13, s[28:31], s83 offen sc1
    buffer_load_dwordx3 v[152:154], v13, s[28:31], s83 offen offset:3072 sc1
    s_waitcnt vmcnt(0)
    s_branch hookA_chk
poll_5:
    s_sleep 6
polln_5:
    buffer_load_dword v140, v31, s[32:35], s3 offen sc1
    buffer_load_dword v141, v31, s[32:35], s3 offen offset:256 sc1
    buffer_load_dword v142, v31, s[32:35], s3 offen offset:512 sc1
    buffer_load_dword v143, v31, s[32:35], s3 offen offset:768 sc1
    buffer_load_dword v144, v31, s[32:35], s3 offen offset:1024 sc1
    buffer_load_dword v145, v31, s[32:35], s3 offen offset:1280 sc1
    buffer_load_dword v146, v31, s[32:35], s3 offen offset:1536 sc1
    buffer_load_dword v147, v31, s[32:35], s3 offen offset:1792 sc1
    s_waitcnt vmcnt(0)
entry_5:
    v_mfma_f32_16x16x32_bf16 v[132:135], v[68:71], v[140:143], 0
    v_mfma_f32_16x16x32_bf16 v[132:135], v[68:71], v[144:147], v[132:135]
    s_cmp_eq_u32 s77, 2
    s_nop 6
    v_cmp_u_f32 vcc, v132, v133
    s_cbranch_vccnz retry_5
cont_5:
    v_pk_add_f32 v[132:133], v[132:133], v[58:59]
    v_cvt_pk_bf16_f32 v49, v132, v133
    s_cbranch_scc1 FINAL
xin_5:
    ds_write_b32 v10, v49
    v_lshlrev_b32 v58, 16, v49
    v_and_b32 v59, 0xffff0000, v49
    v_mul_f32 v63, v58, v58
    v_add_f32 v62, v58, v59
    v_fma_f32 v63, v59, v59, v63
    s_nop 0
    v_add_f32_dpp v62, v62, v62 row_ror:8 row_mask:0xf bank_mask:0xf
    v_add_f32_dpp v63, v63, v63 row_ror:8 row_mask:0xf bank_mask:0xf
    s_nop 0
    v_add_f32_dpp v62, v62, v62 row_ror:4 row_mask:0xf bank_mask:0xf
    v_add_f32_dpp v63, v63, v63 row_ror:4 row_mask:0xf bank_mask:0xf
    s_nop 0
    v_add_f32_dpp v62, v62, v62 row_ror:2 row_mask:0xf bank_mask:0xf
    v_add_f32_dpp v63, v63, v63 row_ror:2 row_mask:0xf bank_mask:0xf
    s_nop 0
    v_add_f32_dpp v62, v62, v62 row_ror:1 row_mask:0xf bank_mask:0xf
    v_add_f32_dpp v63, v63, v63 row_ror:1 row_mask:0xf bank_mask:0xf
    s_cmp_lg_u32 s76, 0
    s_cbranch_scc1 slow_s5
fast_s5:
    buffer_store_dwordx2 v[62:63], v15, s[28:31], s73 offen offset:512
back_s5:
    s_waitcnt lgkmcnt(0)
    s_barrier
    ds_read_b128 v[96:99], v11 offset:0
    ds_read_b128 v[100:103], v11 offset:64
    ds_read_b128 v[104:107], v11 offset:128
    ds_read_b128 v[108:111], v11 offset:192
    s_waitcnt lgkmcnt(3)
    v_mfma_f32_16x16x32_bf16 v[128:131], v[176:179], v[96:99], 0
    s_waitcnt lgkmcnt(2)
    v_mfma_f32_16x16x32_bf16 v[128:131], v[180:183], v[100:103], v[128:131]
    s_waitcnt lgkmcnt(1)
    v_mfma_f32_16x16x32_bf16 v[128:131], v[184:187], v[104:107], v[128:131]
    s_waitcnt lgkmcnt(0)
    v_mfma_f32_16x16x32_bf16 v[128:131], v[188:191], v[108:111], v[128:131]
    s_cmp_lg_u32 s76, 0
    s_nop 5
    s_cbranch_scc1 slow_1
fast_1:
    buffer_store_dwordx4 v[128:131], v14, s[28:31], s73 offen
back_1:
poll_1:
    buffer_load_dwordx2 v[244:245], v16, s[28:31], s73 offen sc1
    buffer_load_dwordx2 v[246:247], v16, s[28:31], s73 offen offset:2048 sc1
    buffer_load_dwordx2 v[248:249], v16, s[28:31], s74 offen sc1
    buffer_load_dwordx2 v[172:173], v16, s[28:31], s74 offen offset:2048 sc1
    buffer_load_dwordx2 v[174:175], v17, s[28:31], s73 offen offset:512 sc1
    s_sleep 3
    buffer_load_dwordx2 v[232:233], v16, s[28:31], s73 offen sc1
    buffer_load_dwordx2 v[234:235], v16, s[28:31], s73 offen offset:2048 sc1
    buffer_load_dwordx2 v[236:237], v16, s[28:31], s74 offen sc1
    buffer_load_dwordx2 v[238:239], v16, s[28:31], s74 offen offset:2048 sc1
    buffer_load_dwordx2 v[240:241], v17, s[28:31], s73 offen offset:512 sc1
    s_waitcnt vmcnt(5)
entry_1:
    v_add_f32_dpp v62, v174, v174 row_ror:8 row_mask:0xf bank_mask:0xf
    v_add_f32_dpp v63, v175, v175 row_ror:8 row_mask:0xf bank_mask:0xf
    v_pk_add_f32 v[132:133], v[244:245], v[246:247]
    v_pk_add_f32 v[134:135], v[248:249], v[172:173]
    v_cmp_u_f32 s[26:27], v174, v175
    v_pk_add_f32 v[64:65], v[132:133], v[134:135]
    v_add_f32_dpp v62, v62, v62 row_ror:4 row_mask:0xf bank_mask:0xf
    v_add_f32_dpp v63, v63, v63 row_ror:4 row_mask:0xf bank_mask:0xf
    v_cmp_u_f32 vcc, v64, v65
    v_add_f32_dpp v62, v62, v62 row_ror:2 row_mask:0xf bank_mask:0xf
    v_add_f32_dpp v63, v63, v63 row_ror:2 row_mask:0xf bank_mask:0xf
    s_or_b64 vcc, vcc, s[26:27]
    s_cbranch_vccnz retry_1
cont_1:
    v_add_f32_dpp v62, v62, v62 row_ror:1 row_mask:0xf bank_mask:0xf
    v_add_f32_dpp v63, v63, v63 row_ror:1 row_mask:0xf bank_mask:0xf
    v_mul_f32 v4, 0x3b000000, v62
    v_fmamk_f32 v5, v63, 0x3b000000, v47
    v_fma_f32 v5, -v4, v4, v5
    v_max_f32 v5, v5, v47
    v_rsq_f32 v5, v5
    v_fma_f32 v64, -v4, v60, v64
    v_fma_f32 v65, -v4, v61, v65
    v_mul_f32 v64, v64, v5
    v_mul_f32 v65, v65, v5
q_ready:
    v_cvt_pk_bf16_f32 v4, v64, v65
    ds_write_b32 v18, v4
    s_waitcnt lgkmcnt(0)
    s_barrier
    ds_read_b128 v[96:99], v19 offset:0
    ds_read_b128 v[100:103], v19 offset:64
    ds_read_b128 v[104:107], v19 offset:128
    ds_read_b128 v[108:111], v19 offset:192
    s_waitcnt lgkmcnt(3)
    v_mfma_f32_16x16x32_bf16 v[128:131], a[0:3], v[96:99], 0
    v_mfma_f32_16x16x32_bf16 v[132:135], a[16:19], v[96:99], 0
    s_waitcnt lgkmcnt(2)
    v_mfma_f32_16x16x32_bf16 v[128:131], a[4:7], v[100:103], v[128:131]
    v_mfma_f32_16x16x32_bf16 v[132:135], a[20:23], v[100:103], v[132:135]
    s_waitcnt lgkmcnt(1)
    v_mfma_f32_16x16x32_bf16 v[128:131], a[8:11], v[104:107], v[128:131]
    v_mfma_f32_16x16x32_bf16 v[132:135], a[24:27], v[104:107], v[132:135]
    s_waitcnt lgkmcnt(0)
    v_mfma_f32_16x16x32_bf16 v[128:131], a[12:15], v[108:111], v[128:131]
    v_mfma_f32_16x16x32_bf16 v[132:135], a[28:31], v[108:111], v[132:135]
    s_cmp_eq_u32 s77, 0
    s_nop 5
    v_max3_f32 v4, v128, v129, v130
    v_max3_f32 v5, v132, v133, v134
    v_max3_f32 v4, v4, v131, v135
    v_max_f32 v4, v4, v5
    v_max_f32 v5, v4, v5
    s_nop 1
    v_permlane16_swap_b32 v4, v5
    v_max_f32 v6, v4, v5
    v_max_f32 v7, v4, v5
    s_nop 1
    v_permlane32_swap_b32 v6, v7
    v_max_f32 v4, v6, v7
    v_mul_f32 v52, s80, v4
    v_fma_f32 v128, v128, s80, -v52
    v_fma_f32 v129, v129, s80, -v52
    v_fma_f32 v130, v130, s80, -v52
    v_fma_f32 v131, v131, s80, -v52
    v_fma_f32 v132, v132, s80, -v52
    v_fma_f32 v133, v133, s80, -v52
    v_fma_f32 v134, v134, s80, -v52
    v_fma_f32 v135, v135, s80, -v52
    v_exp_f32 v128, v128
    v_exp_f32 v129, v129
    v_exp_f32 v130, v130
    v_exp_f32 v131, v131
    v_exp_f32 v132, v132
    v_exp_f32 v133, v133
    v_exp_f32 v134, v134
    v_exp_f32 v135, v135
    v_cvt_pk_bf16_f32 v92, v128, v129
    v_cvt_pk_bf16_f32 v93, v130, v131
    v_cvt_pk_bf16_f32 v94, v132, v133
    v_cvt_pk_bf16_f32 v95, v134, v135
    s_cbranch_scc1 hookD
backD:
    s_nop 0
    v_mfma_f32_16x16x32_bf16 v[136:139], v[72:75], v[92:95], 0
    v_mov_b32_dpp v76, v92 quad_perm:[0,1,2,3] row_mask:0xf bank_mask:0x1
    v_mov_b32_dpp v77, v93 quad_perm:[0,1,2,3] row_mask:0xf bank_mask:0x1
    v_mov_b32_dpp v78, v94 quad_perm:[0,1,2,3] row_mask:0xf bank_mask:0x1
    v_mov_b32_dpp v79, v95 quad_perm:[0,1,2,3] row_mask:0xf bank_mask:0x1
    s_waitcnt lgkmcnt(14)
    s_nop 0
    v_mfma_f32_16x16x32_bf16 v[112:115], a[32:35], v[76:79], 0
    v_mov_b32_dpp v80, v92 quad_perm:[0,1,2,3] row_mask:0xf bank_mask:0x2
    v_mov_b32_dpp v81, v93 quad_perm:[0,1,2,3] row_mask:0xf bank_mask:0x2
    s_waitcnt lgkmcnt(12)
    v_mfma_f32_16x16x32_bf16 v[116:119], a[36:39], v[76:79], 0
    v_mov_b32_dpp v82, v94 quad_perm:[0,1,2,3] row_mask:0xf bank_mask:0x2
    v_mov_b32_dpp v83, v95 quad_perm:[0,1,2,3] row_mask:0xf bank_mask:0x2
    s_waitcnt lgkmcnt(10)
    s_nop 0
    v_mfma_f32_16x16x32_bf16 v[112:115], a[40:43], v[80:83], v[112:115]
    v_mov_b32_dpp v84, v92 quad_perm:[0,1,2,3] row_mask:0xf bank_mask:0x4
    v_mov_b32_dpp v85, v93 quad_perm:[0,1,2,3] row_mask:0xf bank_mask:0x4
    s_waitcnt lgkmcnt(8)
    v_mfma_f32_16x16x32_bf16 v[116:119], a[44:47], v[80:83], v[116:119]
    v_mov_b32_dpp v86, v94 quad_perm:[0,1,2,3] row_mask:0xf bank_mask:0x4
    v_mov_b32_dpp v87, v95 quad_perm:[0,1,2,3] row_mask:0xf bank_mask:0x4
    s_waitcnt lgkmcnt(6)
    s_nop 0
    v_mfma_f32_16x16x32_bf16 v[112:115], a[48:51], v[84:87], v[112:115]
    v_mov_b32_dpp v88, v92 quad_perm:[0,1,2,3] row_mask:0xf bank_mask:0x8
    v_mov_b32_dpp v89, v93 quad_perm:[0,1,2,3] row_mask:0xf bank_mask:0x8
    s_waitcnt lgkmcnt(4)
    v_mfma_f32_16x16x32_bf16 v[116:119], a[52:55], v[84:87], v[116:119]
    v_mov_b32_dpp v90, v94 quad_perm:[0,1,2,3] row_mask:0xf bank_mask:0x8
    v_mov_b32_dpp v91, v95 quad_perm:[0,1,2,3] row_mask:0xf bank_mask:0x8
    s_waitcnt lgkmcnt(2)
    s_nop 0
    v_mfma_f32_16x16x32_bf16 v[112:115], a[56:59], v[88:91], v[112:115]
    s_waitcnt lgkmcnt(0)
    ds_write2_b32 v21, v52, v136 offset0:0 offset1:1
    v_mfma_f32_16x16x32_bf16 v[116:119], a[60:63], v[88:91], v[116:119]
    s_nop 4
    ds_write_b128 v20, v[112:115]
    s_nop 1
    ds_write_b128 v20, v[116:119] offset:64
    s_waitcnt lgkmcnt(0)
    s_barrier
    ds_read_b128 v[140:143], v23
    ds_read_b128 v[144:147], v23 offset:16
    ds_read_b64 v[148:149], v22 offset:0
    ds_read_b64 v[150:151], v22 offset:2432
    ds_read_b64 v[152:153], v22 offset:4864
    ds_read_b64 v[154:155], v22 offset:7296
    s_waitcnt lgkmcnt(4)
    v_max3_f32 v4, v140, v142, v144
    v_max_f32 v66, v4, v146
    v_sub_f32 v140, v140, v66
    v_sub_f32 v142, v142, v66
    v_sub_f32 v144, v144, v66
    v_sub_f32 v146, v146, v66
    v_exp_f32 v140, v140
    v_exp_f32 v142, v142
    v_exp_f32 v144, v144
    v_exp_f32 v146, v146
    s_waitcnt lgkmcnt(0)
    v_pk_mul_f32 v[128:129], v[148:149], v[140:141] op_sel_hi:[1,0]
    v_mul_f32 v67, v140, v141
    v_pk_fma_f32 v[128:129], v[150:151], v[142:143], v[128:129] op_sel_hi:[1,0,1]
    v_fma_f32 v67, v142, v143, v67
    v_pk_fma_f32 v[128:129], v[152:153], v[144:145], v[128:129] op_sel_hi:[1,0,1]
    v_fma_f32 v67, v144, v145, v67
    v_pk_fma_f32 v[128:129], v[154:155], v[146:147], v[128:129] op_sel_hi:[1,0,1]
    v_fma_f32 v67, v146, v147, v67
    v_cvt_pk_bf16_f32 v4, v128, v129
    s_cmp_lg_u32 s76, 0
    s_cbranch_scc1 slow_2
fast_2:
    buffer_store_dword v4, v24, s[28:31], s73 offen
    buffer_store_dwordx2 v[66:67], v25, s[28:31], s73 offen
back_2:
    s_cmp_eq_u32 s77, 0
    s_cbranch_scc1 hookE
poll_2:
    buffer_load_dwordx4 v[140:143], v26, s[28:31], s73 offen sc1
    buffer_load_dwordx4 v[144:147], v26, s[28:31], s73 offen offset:1024 sc1
    buffer_load_dwordx4 v[148:151], v27, s[28:31], s73 offen sc1
    s_sleep 3
wait_2:
    buffer_load_dwordx4 v[232:235], v26, s[28:31], s73 offen sc1
    buffer_load_dwordx4 v[236:239], v26, s[28:31], s73 offen offset:1024 sc1
    buffer_load_dwordx4 v[240:243], v27, s[28:31], s73 offen sc1
    s_waitcnt vmcnt(3)
entry_2:
    ds_write_b128 v28, v[140:143]
    ds_write_b128 v28, v[144:147] offset:1088
    v_max3_u32 v4, v140, v141, v142
    v_max3_u32 v5, v143, v144, v145
    v_max3_u32 v6, v146, v147, v148
    v_max3_u32 v4, v4, v149, v150
    v_max3_u32 v5, v5, v151, v6
    v_pk_mov_b32 v[156:157], v[148:149], v[148:149] op_sel:[0,1]
    v_max_u32 v4, v4, v5
    v_pk_mov_b32 v[158:159], v[150:151], v[150:151] op_sel:[0,1]
    v_cmp_eq_u32 vcc, s79, v4
    s_cbranch_vccnz retry_2
cont_2:
    v_max_f32 v4, v156, v158
    s_cmp_eq_u32 s77, 0
    s_cbranch_scc1 hookW
backW:
    s_waitcnt lgkmcnt(0)
    s_barrier
    ds_read_b128 v[96:99], v29 offset:0
    ds_read_b128 v[112:115], v29 offset:4352
    ds_read_b128 v[100:103], v29 offset:64
    ds_read_b128 v[116:119], v29 offset:4416
    ds_read_b128 v[104:107], v29 offset:128
    ds_read_b128 v[120:123], v29 offset:4480
    ds_read_b128 v[108:111], v29 offset:192
    ds_read_b128 v[124:127], v29 offset:4544
    v_max_f32_dpp v4, v4, v4 row_ror:8 row_mask:0xf bank_mask:0xf
    s_nop 1
    v_max_f32_dpp v4, v4, v4 row_ror:4 row_mask:0xf bank_mask:0xf
    s_nop 1
    v_max_f32_dpp v4, v4, v4 row_ror:2 row_mask:0xf bank_mask:0xf
    s_nop 1
    v_max_f32_dpp v4, v4, v4 row_ror:1 row_mask:0xf bank_mask:0xf
    v_sub_f32 v5, v156, v4
    v_sub_f32 v6, v158, v4
    v_exp_f32 v5, v5
    v_exp_f32 v6, v6
    s_waitcnt lgkmcnt(7)
    v_mfma_f32_16x16x32_bf16 v[128:131], v[192:195], v[96:99], 0
    v_mul_f32 v7, v5, v157
    s_waitcnt lgkmcnt(6)
    v_mfma_f32_16x16x32_bf16 v[132:135], v[192:195], v[112:115], 0
    v_fma_f32 v7, v6, v159, v7
    s_waitcnt lgkmcnt(5)
    v_mfma_f32_16x16x32_bf16 v[128:131], v[196:199], v[100:103], v[128:131]
    v_add_f32_dpp v7, v7, v7 row_ror:8 row_mask:0xf bank_mask:0xf
    s_waitcnt lgkmcnt(4)
    v_mfma_f32_16x16x32_bf16 v[132:135], v[196:199], v[116:119], v[132:135]
    v_add_f32_dpp v7, v7, v7 row_ror:4 row_mask:0xf bank_mask:0xf
    s_waitcnt lgkmcnt(3)
    v_mfma_f32_16x16x32_bf16 v[128:131], v[200:203], v[104:107], v[128:131]
    v_add_f32_dpp v7, v7, v7 row_ror:2 row_mask:0xf bank_mask:0xf
    s_waitcnt lgkmcnt(2)
    v_mfma_f32_16x16x32_bf16 v[132:135], v[200:203], v[120:123], v[132:135]
    v_add_f32_dpp v7, v7, v7 row_ror:1 row_mask:0xf bank_mask:0xf
    s_waitcnt lgkmcnt(1)
    v_mfma_f32_16x16x32_bf16 v[128:131], v[204:207], v[108:111], v[128:131]
    v_rcp_f32 v7, v7
    s_waitcnt lgkmcnt(0)
    v_mfma_f32_16x16x32_bf16 v[132:135], v[204:207], v[124:127], v[132:135]
    v_mul_f32 v53, v5, v7
    v_mul_f32 v54, v6, v7
    s_nop 2
    v_mul_f32 v128, v128, v53
    v_mul_f32 v129, v129, v53
    v_mul_f32 v130, v130, v53
    v_mul_f32 v131, v131, v53
    v_fma_f32 v128, v132, v54, v128
    v_fma_f32 v129, v133, v54, v129
    v_fma_f32 v130, v134, v54, v130
    v_fma_f32 v131, v135, v54, v131
    v_add_f32_dpp v128, v128, v128 row_ror:8 row_mask:0xf bank_mask:0xf
    v_add_f32_dpp v129, v129, v129 row_ror:8 row_mask:0xf bank_mask:0xf
    v_add_f32_dpp v130, v130, v130 row_ror:8 row_mask:0xf bank_mask:0xf
    v_add_f32_dpp v131, v131, v131 row_ror:8 row_mask:0xf bank_mask:0xf
    v_add_f32_dpp v128, v128, v128 row_ror:4 row_mask:0xf bank_mask:0xf
    v_add_f32_dpp v129, v129, v129 row_ror:4 row_mask:0xf bank_mask:0xf
    v_add_f32_dpp v130, v130, v130 row_ror:4 row_mask:0xf bank_mask:0xf
    v_add_f32_dpp v131, v131, v131 row_ror:4 row_mask:0xf bank_mask:0xf
    v_add_f32_dpp v128, v128, v128 row_ror:2 row_mask:0xf bank_mask:0xf
    v_add_f32_dpp v129, v129, v129 row_ror:2 row_mask:0xf bank_mask:0xf
    v_add_f32_dpp v130, v130, v130 row_ror:2 row_mask:0xf bank_mask:0xf
    v_add_f32_dpp v131, v131, v131 row_ror:2 row_mask:0xf bank_mask:0xf
    v_add_f32_dpp v128, v128, v128 row_ror:1 row_mask:0xf bank_mask:0xf
    v_add_f32_dpp v129, v129, v129 row_ror:1 row_mask:0xf bank_mask:0xf
    v_add_f32_dpp v130, v130, v130 row_ror:1 row_mask:0xf bank_mask:0xf
    v_add_f32_dpp v131, v131, v131 row_ror:1 row_mask:0xf bank_mask:0xf
    v_cvt_pk_bf16_f32 v136, v128, v129
    v_cvt_pk_bf16_f32 v137, v130, v131
    s_cbranch_execz dry_done
    buffer_store_dwordx2 v[136:137], v30, s[32:35], s75 offen sc1
    s_add_u32 s3, s75, 32768
    s_cmp_eq_u32 s77, 0
    s_cbranch_scc1 hookX
    s_waitcnt vmcnt(0)
backW2:
poll_3:
    s_sleep 4
polln_3:
    buffer_load_dword v140, v31, s[32:35], s75 offen sc1
    buffer_load_dword v141, v31, s[32:35], s75 offen offset:256 sc1
    buffer_load_dword v142, v31, s[32:35], s75 offen offset:512 sc1
    buffer_load_dword v143, v31, s[32:35], s75 offen offset:768 sc1
    buffer_load_dword v144, v31, s[32:35], s75 offen offset:1024 sc1
    buffer_load_dword v145, v31, s[32:35], s75 offen offset:1280 sc1
    buffer_load_dword v146, v31, s[32:35], s75 offen offset:1536 sc1
    buffer_load_dword v147, v31, s[32:35], s75 offen offset:1792 sc1
    s_waitcnt vmcnt(0)
entry_3:
    v_mfma_f32_16x16x32_bf16 v[132:135], v[68:71], v[140:143], 0
    v_mfma_f32_16x16x32_bf16 v[132:135], v[68:71], v[144:147], v[132:135]
    s_nop 7
    v_cmp_u_f32 vcc, v132, v133
    s_cbranch_vccnz retry_3
cont_3:
    v_pk_add_f32 v[132:133], v[132:133], v[58:59]
    v_cvt_pk_bf16_f32 v49, v132, v133
xin_3:
    ds_write_b32 v10, v49
    v_lshlrev_b32 v58, 16, v49
    v_and_b32 v59, 0xffff0000, v49
    v_mul_f32 v63, v58, v58
    v_add_f32 v62, v58, v59
    v_fma_f32 v63, v59, v59, v63
    s_nop 0
    v_add_f32_dpp v62, v62, v62 row_ror:8 row_mask:0xf bank_mask:0xf
    v_add_f32_dpp v63, v63, v63 row_ror:8 row_mask:0xf bank_mask:0xf
    s_nop 0
    v_add_f32_dpp v62, v62, v62 row_ror:4 row_mask:0xf bank_mask:0xf
    v_add_f32_dpp v63, v63, v63 row_ror:4 row_mask:0xf bank_mask:0xf
    s_nop 0
    v_add_f32_dpp v62, v62, v62 row_ror:2 row_mask:0xf bank_mask:0xf
    v_add_f32_dpp v63, v63, v63 row_ror:2 row_mask:0xf bank_mask:0xf
    s_nop 0
    v_add_f32_dpp v62, v62, v62 row_ror:1 row_mask:0xf bank_mask:0xf
    v_add_f32_dpp v63, v63, v63 row_ror:1 row_mask:0xf bank_mask:0xf
    s_cmp_lg_u32 s76, 0
    s_cbranch_scc1 slow_s3
fast_s3:
    buffer_store_dwordx2 v[62:63], v15, s[28:31], s73 offen
back_s3:
    s_waitcnt lgkmcnt(0)
    s_barrier
    ds_read_b128 v[96:99], v11 offset:0
    ds_read_b128 v[100:103], v11 offset:64
    ds_read_b128 v[104:107], v11 offset:128
    ds_read_b128 v[108:111], v11 offset:192
    s_waitcnt lgkmcnt(3)
    v_mfma_f32_16x16x32_bf16 v[128:131], v[208:211], v[96:99], 0
    s_waitcnt lgkmcnt(2)
    v_mfma_f32_16x16x32_bf16 v[128:131], v[212:215], v[100:103], v[128:131]
    s_waitcnt lgkmcnt(1)
    v_mfma_f32_16x16x32_bf16 v[128:131], v[216:219], v[104:107], v[128:131]
    s_waitcnt lgkmcnt(0)
    v_mfma_f32_16x16x32_bf16 v[128:131], v[220:223], v[108:111], v[128:131]
    s_cmp_lg_u32 s76, 0
    s_nop 5
    s_cbranch_scc1 slow_4
fast_4:
    buffer_store_dwordx4 v[128:131], v32, s[28:31], s73 offen
back_4:
    s_cmp_eq_u32 s77, 0
    s_cbranch_scc1 hookG
poll_4:
    buffer_load_dword v148, v33, s[28:31], s73 offen sc1
    buffer_load_dword v149, v33, s[28:31], s73 offen offset:1024 sc1
    buffer_load_dword v150, v33, s[28:31], s73 offen offset:2048 sc1
    buffer_load_dword v151, v33, s[28:31], s73 offen offset:3072 sc1
    buffer_load_dwordx2 v[152:153], v17, s[28:31], s73 offen sc1
    s_sleep 3
    buffer_load_dword v232, v33, s[28:31], s73 offen sc1
    buffer_load_dword v233, v33, s[28:31], s73 offen offset:1024 sc1
    buffer_load_dword v234, v33, s[28:31], s73 offen offset:2048 sc1
    buffer_load_dword v235, v33, s[28:31], s73 offen offset:3072 sc1
    buffer_load_dwordx2 v[236:237], v17, s[28:31], s73 offen sc1
    s_waitcnt vmcnt(5)
entry_4:
    v_add_f32_dpp v62, v152, v152 row_ror:8 row_mask:0xf bank_mask:0xf
    v_add_f32_dpp v63, v153, v153 row_ror:8 row_mask:0xf bank_mask:0xf
    v_pk_add_f32 v[132:133], v[148:149], v[150:151]
    v_cmp_u_f32 s[26:27], v152, v153
    v_add_f32_dpp v62, v62, v62 row_ror:4 row_mask:0xf bank_mask:0xf
    v_add_f32_dpp v63, v63, v63 row_ror:4 row_mask:0xf bank_mask:0xf
    v_add_f32 v140, v132, v133
    v_add_f32_dpp v62, v62, v62 row_ror:2 row_mask:0xf bank_mask:0xf
    v_cmp_u_f32 vcc, v140, v140
    v_add_f32_dpp v63, v63, v63 row_ror:2 row_mask:0xf bank_mask:0xf
    s_or_b64 vcc, vcc, s[26:27]
    s_cbranch_vccnz retry_4
cont_4:
    v_add_f32_dpp v62, v62, v62 row_ror:1 row_mask:0xf bank_mask:0xf
    v_add_f32_dpp v63, v63, v63 row_ror:1 row_mask:0xf bank_mask:0xf
    v_mul_f32 v4, 0x3b000000, v62
    v_fmamk_f32 v5, v63, 0x3b000000, v47
    v_fma_f32 v5, -v4, v4, v5
    v_max_f32 v5, v5, v47
    v_rsq_f32 v5, v5
    v_fma_f32 v140, -v4, v46, v140
    v_mul_f32 v140, v140, v5
    v_mul_f32 v6, 0xbfb8aa3b, v140
    v_exp_f32 v6, v6
    s_nop 0
    v_add_f32 v6, 1.0, v6
    v_rcp_f32 v6, v6
    s_nop 0
    v_mul_f32 v140, v140, v6
    s_nop 1
    v_mov_b32_dpp v7, v140 quad_perm:[1,0,3,2] row_mask:0xf bank_mask:0xf
    v_cvt_pk_bf16_f32 v7, v140, v7
    s_nop 1
    v_mov_b32_dpp v96, v7 row_newbcast:0 row_mask:0xf bank_mask:0xf
    v_mov_b32_dpp v97, v7 row_newbcast:2 row_mask:0xf bank_mask:0xf
    v_mov_b32_dpp v98, v7 row_newbcast:4 row_mask:0xf bank_mask:0xf
    v_mov_b32_dpp v99, v7 row_newbcast:6 row_mask:0xf bank_mask:0xf
    v_mov_b32_dpp v100, v7 row_newbcast:8 row_mask:0xf bank_mask:0xf
    v_mov_b32_dpp v101, v7 row_newbcast:10 row_mask:0xf bank_mask:0xf
    v_mfma_f32_16x16x32_bf16 v[128:131], v[224:227], v[96:99], 0
    v_mov_b32_dpp v102, v7 row_newbcast:12 row_mask:0xf bank_mask:0xf
    v_mov_b32_dpp v103, v7 row_newbcast:14 row_mask:0xf bank_mask:0xf
    s_nop 1
    v_mfma_f32_16x16x32_bf16 v[128:131], v[228:231], v[100:103], v[128:131]
    s_nop 7
    v_cvt_pk_bf16_f32 v136, v128, v129
    v_cvt_pk_bf16_f32 v137, v130, v131
    s_cbranch_execz dry_done
    buffer_store_dwordx2 v[136:137], v30, s[32:35], s3 offen sc1
    s_cmp_eq_u32 s77, 0
    s_cbranch_scc1 hookH
    s_or_b32 s26, s69, s72
    s_cbranch_scc1 EXIT
    s_mov_b32 s77, 2
    s_waitcnt vmcnt(0)
    s_branch polln_5
retry_5:
    s_sub_u32 s78, s78, 1
    s_cbranch_scc0 polln_5
    s_mov_b32 s78, 0
    s_cmp_eq_u32 s77, 2
    s_branch cont_5
slow_s5:
    s_cbranch_execz back_s5
    s_cmp_eq_u32 s76, 2
    s_cbranch_scc1 back_s5
slow2_s5:
    buffer_store_dwordx2 v[62:63], v15, s[28:31], s73 offen offset:512 sc1
    s_nop 1
    s_branch back_s5
slow_1:
    s_cbranch_execz dry_done
slow2_1:
    buffer_store_dwordx4 v[128:131], v14, s[28:31], s73 offen sc1
    s_nop 1
    s_branch back_1
retry_1:
    buffer_load_dwordx2 v[244:245], v16, s[28:31], s73 offen sc1
    buffer_load_dwordx2 v[246:247], v16, s[28:31], s73 offen offset:2048 sc1
    buffer_load_dwordx2 v[248:249], v16, s[28:31], s74 offen sc1
    buffer_load_dwordx2 v[172:173], v16, s[28:31], s74 offen offset:2048 sc1
    buffer_load_dwordx2 v[174:175], v17, s[28:31], s73 offen offset:512 sc1
    s_waitcnt vmcnt(5)
    v_add_f32_dpp v62, v240, v240 row_ror:8 row_mask:0xf bank_mask:0xf
    v_add_f32_dpp v63, v241, v241 row_ror:8 row_mask:0xf bank_mask:0xf
    v_pk_add_f32 v[132:133], v[232:233], v[234:235]
    v_pk_add_f32 v[134:135], v[236:237], v[238:239]
    v_cmp_u_f32 s[26:27], v240, v241
    v_pk_add_f32 v[64:65], v[132:133], v[134:135]
    v_add_f32_dpp v62, v62, v62 row_ror:4 row_mask:0xf bank_mask:0xf
    v_add_f32_dpp v63, v63, v63 row_ror:4 row_mask:0xf bank_mask:0xf
    v_cmp_u_f32 vcc, v64, v65
    v_add_f32_dpp v62, v62, v62 row_ror:2 row_mask:0xf bank_mask:0xf
    v_add_f32_dpp v63, v63, v63 row_ror:2 row_mask:0xf bank_mask:0xf
    s_or_b64 vcc, vcc, s[26:27]
    s_cbranch_vccz cont_1
    s_sub_u32 s78, s78, 1
    s_cbranch_scc1 giveup_1
    buffer_load_dwordx2 v[232:233], v16, s[28:31], s73 offen sc1
    buffer_load_dwordx2 v[234:235], v16, s[28:31], s73 offen offset:2048 sc1
    buffer_load_dwordx2 v[236:237], v16, s[28:31], s74 offen sc1
    buffer_load_dwordx2 v[238:239], v16, s[28:31], s74 offen offset:2048 sc1
    buffer_load_dwordx2 v[240:241], v17, s[28:31], s73 offen offset:512 sc1
    s_waitcnt vmcnt(5)
    s_branch entry_1
giveup_1:
    s_mov_b32 s78, 0
    s_branch cont_1
slow_2:
    s_cbranch_execz dry_done2
    s_cmp_eq_u32 s76, 2
    s_cbranch_scc1 hookM
slow2_2:
    buffer_store_dword v4, v24, s[28:31], s73 offen sc1
    buffer_store_dwordx2 v[66:67], v25, s[28:31], s73 offen sc1
    s_nop 1
    s_branch back_2
retry_2:
    buffer_load_dwordx4 v[140:143], v26, s[28:31], s73 offen sc1
    buffer_load_dwordx4 v[144:147], v26, s[28:31], s73 offen offset:1024 sc1
    buffer_load_dwordx4 v[148:151], v27, s[28:31], s73 offen sc1
    s_waitcnt vmcnt(3)
    ds_write_b128 v28, v[232:235]
    ds_write_b128 v28, v[236:239] offset:1088
    v_max3_u32 v4, v232, v233, v234
    v_max3_u32 v5, v235, v236, v237
    v_max3_u32 v6, v238, v239, v240
    v_max3_u32 v4, v4, v241, v242
    v_max3_u32 v5, v5, v243, v6
    v_pk_mov_b32 v[156:157], v[240:241], v[240:241] op_sel:[0,1]
    v_max_u32 v4, v4, v5
    v_pk_mov_b32 v[158:159], v[242:243], v[242:243] op_sel:[0,1]
    v_cmp_eq_u32 vcc, s79, v4
    s_cbranch_vccz cont_2
    s_sub_u32 s78, s78, 1
    s_cbranch_scc1 giveup_2
    buffer_load_dwordx4 v[232:235], v26, s[28:31], s73 offen sc1
    buffer_load_dwordx4 v[236:239], v26, s[28:31], s73 offen offset:1024 sc1
    buffer_load_dwordx4 v[240:243], v27, s[28:31], s73 offen sc1
    s_waitcnt vmcnt(3)
    s_branch entry_2
giveup_2:
    s_mov_b32 s78, 0
    s_branch cont_2
retry_3:
    s_sub_u32 s78, s78, 1
    s_cbranch_scc0 polln_3
    s_mov_b32 s78, 0
    s_branch cont_3
slow_s3:
    s_cbranch_execz back_s3
slow2_s3:
    buffer_store_dwordx2 v[62:63], v15, s[28:31], s73 offen sc1
    s_nop 1
    s_branch back_s3
slow_4:
    s_cbranch_execz entry_4
slow2_4:
    buffer_store_dwordx4 v[128:131], v32, s[28:31], s73 offen sc1
    s_nop 1
    s_branch back_4
retry_4:
    buffer_load_dword v148, v33, s[28:31], s73 offen sc1
    buffer_load_dword v149, v33, s[28:31], s73 offen offset:1024 sc1
    buffer_load_dword v150, v33, s[28:31], s73 offen offset:2048 sc1
    buffer_load_dword v151, v33, s[28:31], s73 offen offset:3072 sc1
    buffer_load_dwordx2 v[152:153], v17, s[28:31], s73 offen sc1
    s_waitcnt vmcnt(5)
    v_add_f32_dpp v62, v236, v236 row_ror:8 row_mask:0xf bank_mask:0xf
    v_add_f32_dpp v63, v237, v237 row_ror:8 row_mask:0xf bank_mask:0xf
    v_pk_add_f32 v[132:133], v[232:233], v[234:235]
    v_cmp_u_f32 s[26:27], v236, v237
    v_add_f32_dpp v62, v62, v62 row_ror:4 row_mask:0xf bank_mask:0xf
    v_add_f32_dpp v63, v63, v63 row_ror:4 row_mask:0xf bank_mask:0xf
    v_add_f32 v140, v132, v133
    v_add_f32_dpp v62, v62, v62 row_ror:2 row_mask:0xf bank_mask:0xf
    v_cmp_u_f32 vcc, v140, v140
    v_add_f32_dpp v63, v63, v63 row_ror:2 row_mask:0xf bank_mask:0xf
    s_or_b64 vcc, vcc, s[26:27]
    s_cbranch_vccz cont_4
    s_sub_u32 s78, s78, 1
    s_cbranch_scc1 giveup_4
    buffer_load_dword v232, v33, s[28:31], s73 offen sc1
    buffer_load_dword v233, v33, s[28:31], s73 offen offset:1024 sc1
    buffer_load_dword v234, v33, s[28:31], s73 offen offset:2048 sc1
    buffer_load_dword v235, v33, s[28:31], s73 offen offset:3072 sc1
    buffer_load_dwordx2 v[236:237], v17, s[28:31], s73 offen sc1
    s_waitcnt vmcnt(5)
    s_branch entry_4
giveup_4:
    s_mov_b32 s78, 0
    s_branch cont_4
FINAL:
    s_lshl_b32 s26, s71, 8
    s_sub_u32 s26, s26, 143104
    v_add_u32 v4, s26, v10
    buffer_store_dword v49, v4, s[60:63], 0 offen
    s_or_b32 s26, s71, s68
    s_cbranch_scc1 EXIT
    v_add_u32 v5, 1, v48
    v_mov_b32 v6, 135168
    buffer_store_dword v5, v6, s[32:35], 0 offen sc1
EXIT:
END:
    s_endpgm
hookD:
    s_mul_i32 s84, s68, 4352
    s_add_u32 m0, s84, 17408
    s_mov_b32 s83, 0
    buffer_load_dwordx4 v42, s[48:51], s83 offen nt lds
    s_mul_i32 s84, s68, 4352
    s_add_u32 m0, s84, 18496
    s_mov_b32 s83, 8192
    buffer_load_dwordx4 v42, s[48:51], s83 offen nt lds
    s_mul_i32 s84, s68, 4352
    s_add_u32 m0, s84, 19584
    s_mov_b32 s83, 16384
    buffer_load_dwordx4 v42, s[48:51], s83 offen nt lds
    s_mul_i32 s84, s68, 4352
    s_add_u32 m0, s84, 20672
    s_mov_b32 s83, 24576
    buffer_load_dwordx4 v42, s[48:51], s83 offen nt lds
    s_waitcnt vmcnt(8)
hookD_dry:
    ds_read_b64_tr_b16 a[32:33], v37 offset:0
    ds_read_b64_tr_b16 a[34:35], v37 offset:4608
    ds_read_b64_tr_b16 a[36:37], v38 offset:0
    ds_read_b64_tr_b16 a[38:39], v38 offset:4608
    ds_read_b64_tr_b16 a[40:41], v39 offset:0
    ds_read_b64_tr_b16 a[42:43], v39 offset:4608
    ds_read_b64_tr_b16 a[44:45], v40 offset:0
    ds_read_b64_tr_b16 a[46:47], v40 offset:4608
    ds_read_b64_tr_b16 a[48:49], v37 offset:128
    ds_read_b64_tr_b16 a[50:51], v37 offset:4736
    ds_read_b64_tr_b16 a[52:53], v38 offset:128
    ds_read_b64_tr_b16 a[54:55], v38 offset:4736
    ds_read_b64_tr_b16 a[56:57], v39 offset:128
    ds_read_b64_tr_b16 a[58:59], v39 offset:4736
    ds_read_b64_tr_b16 a[60:61], v40 offset:128
    ds_read_b64_tr_b16 a[62:63], v40 offset:4736
    s_branch backD
hookM:
    s_waitcnt vmcnt(7)
hookD_fl:
    v_xor_b32 v5, s81, v160
    v_xor_b32 v6, s81, v161
    v_xor_b32 v7, s81, v162
    v_xor_b32 v8, s81, v163
    v_or3_b32 v9, v5, v6, v7
    v_or_b32 v9, v9, v8
    v_cmp_lt_u32 vcc, 15, v9
    s_cbranch_vccnz hookD_re
hookD_ok:
    v_xor_b32 v5, s82, v5
    v_xor_b32 v6, s82, v6
    v_xor_b32 v7, s82, v7
    v_xor_b32 v8, s82, v8
    v_or3_b32 v9, v5, v6, v7
    v_or_b32 v9, v9, v8
    v_cmp_ne_u32 vcc, 0, v9
    s_lshl_b32 s26, s69, 3
    s_lshr_b64 s[26:27], vcc, s26
    s_and_b32 s26, s26, 0xff
    s_cselect_b32 s76, 1, 0
    s_cbranch_scc1 slow2_2
    s_branch fast_2
hookD_re:
    s_sub_u32 s78, s78, 1
    s_cbranch_scc0 hookD_re2
    s_mov_b32 s78, 0
    s_branch hookD_ok
hookD_re2:
    v_lshlrev_b32 v53, 4, v1
    v_add_u32 v53, 131072, v53
    buffer_load_dwordx4 v[160:163], v53, s[32:35], 0 offen sc1
    s_waitcnt vmcnt(0)
    s_branch hookD_fl
hookE:
    s_cmp_lg_u32 s76, 0
    s_cbranch_scc1 hookE_slow
    buffer_store_dwordx4 v[164:167], v14, s[28:31], s73 offen
hookE_j:
    buffer_load_dwordx4 v[140:143], v26, s[28:31], s73 offen sc1
    buffer_load_dwordx4 v[144:147], v26, s[28:31], s73 offen offset:1024 sc1
    buffer_load_dwordx4 v[148:151], v27, s[28:31], s73 offen sc1
    s_waitcnt vmcnt(6)
    s_barrier
    ds_read_b64_tr_b16 v[192:193], v34 offset:17408
    ds_read_b64_tr_b16 v[194:195], v34 offset:17920
    ds_read_b64_tr_b16 v[196:197], v34 offset:21760
    ds_read_b64_tr_b16 v[198:199], v34 offset:22272
    ds_read_b64_tr_b16 v[200:201], v34 offset:26112
    ds_read_b64_tr_b16 v[202:203], v34 offset:26624
    ds_read_b64_tr_b16 v[204:205], v34 offset:30464
    ds_read_b64_tr_b16 v[206:207], v34 offset:30976
    s_branch wait_2
hookE_slow:
    buffer_store_dwordx4 v[164:167], v14, s[28:31], s73 offen sc1
    s_branch hookE_j
hookW:
    s_mul_i32 s84, s68, 2048
    s_add_u32 m0, s84, 106496
    s_mov_b32 s83, 0
    buffer_load_dwordx4 v45, s[52:55], s83 offen nt lds
    s_add_u32 m0, s84, 107520
    s_mov_b32 s83, 57344
    buffer_load_dwordx4 v45, s[52:55], s83 offen nt lds
    s_mul_i32 s84, s68, 2176
    s_add_u32 m0, s84, 114688
    s_mov_b32 s83, 0
    buffer_load_dwordx4 v42, s[56:59], s83 offen nt lds
    s_cmp_eq_u32 s68, 3
    s_cbranch_scc1 hookW_3
    s_mul_i32 s84, s68, 2176
    s_add_u32 m0, s84, 115776
    s_mov_b32 s83, 8192
    buffer_load_dwordx4 v42, s[56:59], s83 offen nt lds
hookW_3:
    s_branch backW
hookX:
    s_waitcnt vmcnt(0)
    s_barrier
    v_add_u32 v4, 114688, v34
    ds_read_b64_tr_b16 v[224:225], v4 offset:0
    ds_read_b64_tr_b16 v[226:227], v4 offset:512
    ds_read_b64_tr_b16 v[228:229], v4 offset:4352
    ds_read_b64_tr_b16 v[230:231], v4 offset:4864
    ds_read_b64_tr_b16 v[208:209], v35 offset:0
    ds_read_b64_tr_b16 v[210:211], v35 offset:256
    ds_read_b64_tr_b16 v[212:213], v35 offset:2048
    ds_read_b64_tr_b16 v[214:215], v35 offset:2304
    ds_read_b64_tr_b16 v[216:217], v35 offset:4096
    ds_read_b64_tr_b16 v[218:219], v35 offset:4352
    ds_read_b64_tr_b16 v[220:221], v35 offset:6144
    ds_read_b64_tr_b16 v[222:223], v35 offset:6400
    v_cmp_eq_u32 vcc, 3, v3
    v_mov_b32 v5, 0
    s_waitcnt lgkmcnt(0)
    v_cndmask_b32 v228, v228, v5, vcc
    v_cndmask_b32 v229, v229, v5, vcc
    v_cndmask_b32 v230, v230, v5, vcc
    v_cndmask_b32 v231, v231, v5, vcc
    s_branch polln_3
hookG:
hookG_re:
    buffer_load_dword v144, v33, s[28:31], s74 offen sc1
    buffer_load_dword v145, v33, s[28:31], s74 offen offset:1024 sc1
    buffer_load_dword v146, v33, s[28:31], s74 offen offset:2048 sc1
    buffer_load_dword v147, v33, s[28:31], s74 offen offset:3072 sc1
    buffer_load_dword v148, v33, s[28:31], s73 offen sc1
    buffer_load_dword v149, v33, s[28:31], s73 offen offset:1024 sc1
    buffer_load_dword v150, v33, s[28:31], s73 offen offset:2048 sc1
    buffer_load_dword v151, v33, s[28:31], s73 offen offset:3072 sc1
    buffer_load_dwordx2 v[152:153], v17, s[28:31], s73 offen sc1
    v_mov_b32 v236, s79
    s_waitcnt vmcnt(0)
    v_add_f32 v144, v144, v145
    v_add_f32 v146, v146, v147
    v_add_f32 v46, v144, v146
    v_cmp_u_f32 vcc, v46, v46
    s_cbranch_vccz entry_4
    s_sub_u32 s78, s78, 1
    s_cbranch_scc0 hookG_re
    s_mov_b32 s78, 0
    s_branch entry_4
hookH:
    s_add_u32 s26, s73, 8192
    s_add_u32 s27, s73, 12288
hookH_re:
    buffer_load_dwordx2 v[140:141], v16, s[28:31], s26 offen sc1
    buffer_load_dwordx2 v[142:143], v16, s[28:31], s26 offen offset:2048 sc1
    buffer_load_dwordx2 v[144:145], v16, s[28:31], s27 offen sc1
    buffer_load_dwordx2 v[146:147], v16, s[28:31], s27 offen offset:2048 sc1
    s_waitcnt vmcnt(0)
    v_pk_add_f32 v[140:141], v[140:141], v[142:143]
    v_pk_add_f32 v[144:145], v[144:145], v[146:147]
    v_pk_add_f32 v[60:61], v[140:141], v[144:145]
    v_cmp_u_f32 vcc, v60, v61
    s_cbranch_vccz hookH_ok
    s_sub_u32 s78, s78, 1
    s_cbranch_scc0 hookH_re
    s_mov_b32 s78, 0
hookH_ok:
    s_mov_b32 s73, 0
    s_mov_b32 s74, 4096
    s_mov_b32 s75, 65536
    s_mov_b32 s77, 1
    s_branch poll_5
    s_endpgm
CODE_END:
.section .rodata,"a"
.p2align 6
.amdhsa_kernel interleave_layers__sliding_block_cached__dense_activation_silu__decode_kernel
  .amdhsa_next_free_vgpr 320
  .amdhsa_next_free_sgpr 102
  .amdhsa_accum_offset 256
  .amdhsa_group_segment_fixed_size 0
  .amdhsa_kernarg_size 88
  .amdhsa_user_sgpr_count 2
  .amdhsa_user_sgpr_kernarg_segment_ptr 1
  .amdhsa_system_sgpr_workgroup_id_x 1
.end_amdhsa_kernel
```
